```python
import torch

def _softmax(x, axis=-1):
    return torch.softmax(x, dim=axis)
def _gelu(x):
    return torch.nn.functional.gelu(x, approximate="tanh")
def _silu(x):
    return torch.nn.functional.silu(x)
def _sigmoid(x):
    return torch.sigmoid(x)
def _layernorm(x, axis=-1, eps=1e-5):
    m = x.mean(dim=axis, keepdim=True)
    v = x.var(dim=axis, keepdim=True, unbiased=False)
    return (x - m) / torch.sqrt(v + eps)
def _scatter_add(tgt, idx, src, axis=0):
    return tgt.clone().index_add_(axis, idx, src)
def _segment_sum(src, seg, n):
    out = torch.zeros((n,) + src.shape[1:], dtype=src.dtype)
    return out.index_add_(0, seg, src)
def _pad(x, pw):
    flat = tuple(v for pair in reversed(pw) for v in pair)
    return torch.nn.functional.pad(x, flat)

kernel_name = 'sequential_preLN__sliding_block_cached__dense_activation_gelu__decode'

def setup_inputs():

    _w = (lambda a: (lambda t: t.to(torch.bfloat16) if t.is_floating_point() else t)(torch.as_tensor(a)))
    def _A_setup():
        B, Sq, D = 8, 1, 512
        Hq, Hkv, Sk, Dh = 32, 8, 4096, 128
        assert Hq % Hkv == 0, (Hq, Hkv)
        return {
            "x": _w((lambda *s: torch.randn(*s, dtype=torch.bfloat16) * 0.05)(B, Sq, D)),
            "k_cache": _w((lambda *s: torch.randn(*s, dtype=torch.bfloat16) * 1.6)(B, Hkv, Sk, Dh)),
            "v_cache": _w((lambda *s: torch.randn(*s, dtype=torch.bfloat16) * 0.4)(B, Hkv, Sk, Dh)),
            "wq": _w((lambda *s: torch.randn(*s, dtype=torch.bfloat16) * 1.6)(D, Hq * Dh) * (D ** -0.5)),
            "wo": _w((lambda *s: torch.randn(*s, dtype=torch.bfloat16) * 0.4)(Hq * Dh, D) * ((Hq * Dh) ** -0.5)),
        }
    _A_in = _A_setup()

    def _B_setup():
        B, S, D, F = 8, 1, 512, 1792
        return {
            "x": _w((lambda *s: torch.randn(*s, dtype=torch.bfloat16) * 0.05)(B, S, D)),
            "w1": _w((lambda *s: torch.randn(*s, dtype=torch.bfloat16) * 0.8)(D, F) * (D ** -0.5)),
            "b1": _w((lambda *s: torch.randn(*s, dtype=torch.bfloat16) * 0.8)(F) * 0.01),
            "w2": _w((lambda *s: torch.randn(*s, dtype=torch.bfloat16) * 0.1)(F, D) * (F ** -0.5)),
            "b2": _w((lambda *s: torch.randn(*s, dtype=torch.bfloat16) * 0.1)(D) * 0.01),
        }
    _B_in = _B_setup()

    return {
        "A_x": _A_in["x"],
        "A_k_cache": _A_in["k_cache"],
        "A_v_cache": _A_in["v_cache"],
        "A_wq": _A_in["wq"],
        "A_wo": _A_in["wo"],
        "B_x": _B_in["x"],
        "B_w1": _B_in["w1"],
        "B_b1": _B_in["b1"],
        "B_w2": _B_in["w2"],
        "B_b2": _B_in["b2"],
    }

def reference(A_x, A_k_cache, A_v_cache, A_wq, A_wo, B_x, B_w1, B_b1, B_w2, B_b2):
    def _A_ref(x, k_cache, v_cache, wq, wo):
        B, Sq, D = x.shape
        Hq, Dh = 32, 128
        Hkv, Sk = k_cache.shape[1], k_cache.shape[2]
        W = min(4096, max(256, Sk // 4))
        rep = Hq // Hkv
        q = (lambda x, *d: x.permute(*d))((x @ wq).reshape(B, Sq, Hq, Dh), 0, 2, 1, 3)
        k = (lambda x, n, axis: torch.repeat_interleave(x, n, dim=axis))(k_cache[:, :, Sk - W:, :], rep, axis=1)
        v = (lambda x, n, axis: torch.repeat_interleave(x, n, dim=axis))(v_cache[:, :, Sk - W:, :], rep, axis=1)
        scores = torch.einsum("bhqd,bhkd->bhqk", q, k) * (Dh ** -0.5)
        p = _softmax(scores, axis=-1)
        o = torch.einsum("bhqk,bhkd->bhqd", p, v)
        return (lambda x, *d: x.permute(*d))(o, 0, 2, 1, 3).reshape(B, Sq, Hq * Dh) @ wo

    def _B_ref(x, w1, b1, w2, b2):
        h = torch.einsum("bsd,df->bsf", x, w1) + b1
        h = _gelu(h)
        return torch.einsum("bsf,fd->bsd", h, w2) + b2

    x = A_x
    h = x + _A_ref(_layernorm(x, axis=-1), A_k_cache, A_v_cache, A_wq, A_wo)
    h2 = h + _B_ref(_layernorm(h, axis=-1), B_w1, B_b1, B_w2, B_b2)
    return h2
```

```asm
; @launch grid=(256,1,1) block=(576,1,1) lds=163840
.amdgcn_target "amdgcn-amd-amdhsa--gfx950"
.text
.globl sequential_preLN__sliding_block_cached__dense_activation_gelu__decode_kernel
.p2align 12
.p2align 8
.type sequential_preLN__sliding_block_cached__dense_activation_gelu__decode_kernel,@function
sequential_preLN__sliding_block_cached__dense_activation_gelu__decode_kernel:
    s_cmp_ge_u32 s2, 256
    s_cbranch_scc1 L_end
    s_load_dwordx16 s[4:19], s[0:1], 0
    s_load_dwordx8 s[20:27], s[0:1], 64
    s_load_dwordx2 s[28:29], s[0:1], 96
    v_lshrrev_b32 v1, 6, v0
    v_and_b32 v0, 63, v0
    v_readfirstlane_b32 s32, v1
    s_and_b32 s33, s2, 7
    s_lshr_b32 s34, s2, 3
    s_lshr_b32 s35, s2, 5
    s_and_b32 s36, s34, 3
    s_mov_b32 s37, 0x800000
    v_and_b32 v1, 15, v0
    v_lshrrev_b32 v2, 4, v0
    v_mov_b32 v4, 160128
    v_mov_b32 v5, 1
    s_cmp_eq_u32 s32, 8
    s_cbranch_scc1 L_loader
L_compute:
    s_lshl_b32 s46, s32, 10
    v_lshlrev_b32 v11, 4, v0
    v_add_u32 v11, s46, v11
    v_mov_b32 v20, 0
    v_lshl_add_u32 v12, v1, 2, v4
    ds_write_b32 v12, v20
    v_lshlrev_b32 v12, 1, v2
    v_and_b32 v13, 7, v0
    v_xor_b32 v12, v12, v13
    v_lshlrev_b32 v12, 4, v12
    v_lshrrev_b32 v13, 3, v0
    v_lshl_add_u32 v14, v13, 13, v12
    v_lshl_add_u32 v139, v13, 10, v12
    s_xor_b32 s53, s35, 4
    s_lshl_b32 s47, s36, 20
    s_lshl_b32 s51, s32, 17
    s_add_u32 s47, s47, s51
    s_lshl_b32 s51, s33, 10
    s_add_u32 s47, s47, s51
    s_lshl_b32 s51, s53, 7
    s_add_u32 s47, s47, s51
    s_mov_b32 s42, 4194304
    s_mov_b32 s43, 0x20000
    s_lshl_b32 s48, s32, 11
    s_add_u32 m0, s48, 131072
    s_waitcnt lgkmcnt(0)
    s_mov_b32 s40, s10
    s_mov_b32 s41, s11
    global_load_dwordx4 v[52:55], v11, s[4:5]
    buffer_load_dwordx4 v14, s[40:43], s47 offen nt lds
    s_add_u32 m0, s48, 132096
    s_add_u32 s47, s47, 65536
    buffer_load_dwordx4 v14, s[40:43], s47 offen nt lds
    s_load_dword s30, s[28:29], 0
    s_barrier
    s_cmp_lg_u32 s32, 0
    s_cbranch_scc1 L_nocp
    s_cmp_ge_u32 s34, 3
    s_cbranch_scc1 L_nocp
    s_getpc_b64 s[2:3]
L_pc:
    s_lshl_b32 s46, s34, 12
    v_lshlrev_b32 v21, 6, v0
    v_add_u32 v21, s46, v21
    v_min_u32 v21, L_end-L_pc, v21
    global_load_dword v22, v21, s[2:3]
L_nocp:
    s_branch L_c2
L_loader:
    s_setprio 3
    v_xor_b32 v11, v2, v1
    v_lshlrev_b32 v11, 4, v11
    v_lshl_add_u32 v20, v2, 8, v11
    v_xor_b32 v21, 64, v20
    v_xor_b32 v22, 0x80, v20
    v_xor_b32 v23, 0xc0, v20
    v_lshlrev_b32 v11, 1, v2
    v_xor_b32 v11, v11, v1
    v_lshlrev_b32 v11, 4, v11
    v_lshl_add_u32 v24, v2, 8, v11
    v_xor_b32 v25, 0x80, v24
    s_lshl_b32 s48, s35, 23
    s_lshl_b32 s51, s33, 20
    s_add_u32 s48, s48, s51
    s_lshl_b32 s51, s36, 16
    s_add_u32 s48, s48, s51
    s_add_u32 s48, s48, 786432
    s_mov_b32 s58, 67108864
    s_mov_b32 s59, 0x20000
    s_lshl_b32 s47, s33, 1
    s_add_u32 s47, s47, s34
    s_lshl_b32 s61, s47, 12
    s_lshl_b32 s46, s33, 12
    s_lshl_b32 s51, s34, 7
    s_add_u32 s46, s46, s51
    s_add_u32 s46, s46, 32768
    v_lshlrev_b32 v26, 4, v0
    v_add_u32 v26, s46, v26
    s_getreg_b32 s49, hwreg(HW_REG_XCC_ID)
    s_lshl_b32 s49, s49, 8
    s_waitcnt lgkmcnt(0)
    s_mov_b32 s56, s6
    s_mov_b32 s57, s7
    s_load_dword s30, s[28:29], 0
    s_mov_b32 s62, 0
    s_mov_b64 vcc, 0
    s_and_b32 s46, s34, 0x1e
    s_cmp_eq_u32 s46, 12
    s_cmov_b64 vcc, -1
    s_cmp_eq_u32 s35, 7
    s_cmov_b64 vcc, -1
    s_barrier
L_ldk:
    s_and_b32 s61, s61, 0xffff
    s_add_u32 m0, s61, 0
    s_add_u32 s50, s61, s48
    s_add_u32 s62, s62, 4096
    buffer_load_dwordx4 v20, s[56:59], s50 offen offset:0 nt lds
    buffer_load_dwordx4 v21, s[56:59], s50 offen offset:1024 nt lds
    s_cbranch_vccnz m_1
    s_waitcnt vmcnt(22)
m_1:
    buffer_load_dwordx4 v22, s[56:59], s50 offen offset:2048 nt lds
    buffer_load_dwordx4 v23, s[56:59], s50 offen offset:3072 nt lds
    s_add_u32 s61, s61, 4096
    s_waitcnt vmcnt(32)
    s_cbranch_vccnz w_2
    s_waitcnt vmcnt(22)
w_2:
    s_cmp_lg_u32 s62, 12288
    s_cbranch_scc1 nf_3
    s_waitcnt lgkmcnt(0)
    s_add_u32 s30, s30, 1
    s_and_b32 s30, s30, 0xff
    s_or_b32 s49, s49, s30
    v_mov_b32 v28, s49
    v_mov_b32 v29, s49
    v_mov_b32 v30, s49
    v_mov_b32 v31, s49
    s_mov_b64 exec, 0xff
    global_store_dwordx4 v26, v[28:31], s[28:29] sc1
    s_mov_b64 exec, -1
nf_3:
    s_cmp_lt_u32 s62, 65536
    s_cbranch_scc1 L_ldk
    s_mov_b32 s56, s8
    s_mov_b32 s57, s9
    s_mov_b32 s62, 0
    s_and_b32 s61, s61, 0xe000
    s_mov_b32 s63, 24576
    s_cmp_lg_u64 vcc, 0
    s_cmov_b32 s63, 32768
L_ldv:
    s_and_b32 s61, s61, 0xffff
    s_add_u32 m0, s61, 65536
    s_add_u32 s50, s61, s48
    s_add_u32 s62, s62, 4096
    buffer_load_dwordx4 v24, s[56:59], s50 offen offset:0 nt lds
    buffer_load_dwordx4 v25, s[56:59], s50 offen offset:1024 nt lds
    s_cbranch_vccnz m_5
    s_waitcnt vmcnt(22)
m_5:
    buffer_load_dwordx4 v24, s[56:59], s50 offen offset:2048 nt lds
    buffer_load_dwordx4 v25, s[56:59], s50 offen offset:3072 nt lds
    s_add_u32 s61, s61, 4096
    s_waitcnt vmcnt(32)
    s_cbranch_vccnz w_6
    s_waitcnt vmcnt(22)
w_6:
    s_cmp_lg_u32 s62, s63
    s_cbranch_scc1 nf_7
    ds_write_b32 v4, v5 offset:24
nf_7:
    s_cmp_lt_u32 s62, 65536
    s_cbranch_scc1 L_ldv
    ds_write_b32 v4, v5 offset:32
    s_waitcnt vmcnt(8)
    ds_write_b32 v4, v5 offset:36
    s_waitcnt vmcnt(0)
    s_barrier
    s_branch L_exit
L_c2:
    s_mov_b32 s45, 0xffffff00
    s_and_b32 s55, s32, 3
    v_mov_b32 v148, 0
    v_and_b32 v13, 7, v1
    v_lshrrev_b32 v14, 3, v1
    v_and_b32 v15, 3, v1
    v_lshrrev_b32 v16, 2, v1
    v_and_b32 v18, 1, v2
    v_lshrrev_b32 v17, 1, v2
    v_lshl_add_u32 v17, v18, 1, v17
    v_lshl_add_u32 v11, v2, 2, v16
    v_lshlrev_b32 v12, 7, v11
    v_bfe_u32 v19, v11, 1, 2
    v_xor_b32 v19, s55, v19
    v_lshl_add_u32 v12, v19, 5, v12
    v_lshl_add_u32 v6, v15, 3, v12
    v_lshrrev_b32 v11, 1, v13
    v_and_b32 v12, 1, v13
    v_lshlrev_b32 v12, 6, v12
    v_lshl_add_u32 v12, v2, 4, v12
    s_lshl_b32 s46, s33, 16
    s_lshl_b32 s51, s36, 12
    s_add_u32 s46, s46, s51
    s_lshl_b32 s51, s53, 9
    s_add_u32 s46, s46, s51
    s_lshl_b32 s51, s55, 7
    s_add_u32 s46, s46, s51
    s_add_u32 s46, s46, 524288
    v_lshl_add_u32 v19, v11, 14, v12
    v_add_u32 v24, s46, v19
    s_mul_i32 s46, s32, 1040
    s_add_u32 s46, s46, 147456
    v_lshlrev_b32 v20, 4, v0
    v_add_u32 v20, s46, v20
    v_mul_u32_u24 v11, 1040, v13
    v_lshl_add_u32 v11, v2, 3, v11
    s_lshl_b32 s46, s36, 8
    s_add_u32 s46, s46, 147456
    v_add_u32 v11, s46, v11
    v_add_u32 v138, 131072, v6
    v_mov_b32 v65, 0x3b000000
    s_lshr_b32 s47, s35, 1
    s_and_b32 s48, s35, 1
    s_and_b32 s49, s32, 1
    s_lshl_b32 s46, s33, 16
    s_lshl_b32 s51, s47, 14
    s_add_u32 s46, s46, s51
    s_lshl_b32 s51, s48, 6
    s_add_u32 s46, s46, s51
    s_lshl_b32 s51, s49, 11
    s_add_u32 s46, s46, s51
    s_add_u32 s46, s46, 528384
    v_lshrrev_b32 v25, 2, v0
    v_lshlrev_b32 v25, 7, v25
    v_lshl_add_u32 v25, v15, 4, v25
    v_add_u32 v25, s46, v25
    v_add_u32 v26, 8192, v25
    s_waitcnt lgkmcnt(0)
    s_add_u32 s30, s30, 1
    s_and_b32 s31, s30, 0xff
    v_mov_b32 v3, s31
    s_cmp_eq_u32 s32, 0
    s_cbranch_scc1 L_xw3
    s_waitcnt vmcnt(2)
L_xw3:
    s_cmp_lt_u32 s34, 3
    s_cbranch_scc1 L_xw4
    s_waitcnt vmcnt(2)
L_xw4:
    s_waitcnt vmcnt(3)
L_ln:
    v_lshlrev_b32 v56, 16, v52
    v_and_b32 v57, 0xffff0000, v52
    v_lshlrev_b32 v58, 16, v53
    v_and_b32 v59, 0xffff0000, v53
    v_lshlrev_b32 v60, 16, v54
    v_and_b32 v61, 0xffff0000, v54
    v_lshlrev_b32 v62, 16, v55
    v_and_b32 v63, 0xffff0000, v55
    v_add_f32 v64, v56, v57
    v_add_f32 v68, v58, v59
    v_add_f32 v66, v60, v61
    v_add_f32 v67, v62, v63
    v_add_f32 v64, v64, v68
    v_add_f32 v66, v66, v67
    v_add_f32 v64, v64, v66
    s_nop 1
    v_add_f32_dpp v64, v64, v64 quad_perm:[1,0,3,2] row_mask:0xf bank_mask:0xf
    s_nop 1
    v_add_f32_dpp v64, v64, v64 quad_perm:[2,3,0,1] row_mask:0xf bank_mask:0xf
    s_nop 1
    v_add_f32_dpp v64, v64, v64 row_half_mirror row_mask:0xf bank_mask:0xf
    s_nop 1
    v_add_f32_dpp v64, v64, v64 row_mirror row_mask:0xf bank_mask:0xf
    s_nop 1
    v_add_f32_dpp v64, v64, v64 row_bcast:15 row_mask:0xa bank_mask:0xf
    s_nop 1
    v_add_f32_dpp v64, v64, v64 row_bcast:31 row_mask:0xc bank_mask:0xf
    s_nop 0
    v_readlane_b32 s46, v64, 63
    s_nop 1
    v_mul_f32 v64, s46, v65
    v_sub_f32 v68, v56, v64
    v_sub_f32 v69, v57, v64
    v_sub_f32 v70, v58, v64
    v_sub_f32 v71, v59, v64
    v_sub_f32 v72, v60, v64
    v_sub_f32 v73, v61, v64
    v_sub_f32 v74, v62, v64
    v_sub_f32 v75, v63, v64
    v_mul_f32 v66, v68, v68
    v_mul_f32 v67, v69, v69
    v_fmac_f32 v66, v70, v70
    v_fmac_f32 v67, v71, v71
    v_fmac_f32 v66, v72, v72
    v_fmac_f32 v67, v73, v73
    v_fmac_f32 v66, v74, v74
    v_fmac_f32 v67, v75, v75
    v_add_f32 v66, v66, v67
    v_cvt_pk_bf16_f32 v64, v64, v64
    v_lshlrev_b32 v64, 16, v64
    v_add_f32_dpp v66, v66, v66 quad_perm:[1,0,3,2] row_mask:0xf bank_mask:0xf
    s_nop 1
    v_add_f32_dpp v66, v66, v66 quad_perm:[2,3,0,1] row_mask:0xf bank_mask:0xf
    s_nop 1
    v_add_f32_dpp v66, v66, v66 row_half_mirror row_mask:0xf bank_mask:0xf
    s_nop 1
    v_add_f32_dpp v66, v66, v66 row_mirror row_mask:0xf bank_mask:0xf
    s_nop 1
    v_add_f32_dpp v66, v66, v66 row_bcast:15 row_mask:0xa bank_mask:0xf
    s_nop 1
    v_add_f32_dpp v66, v66, v66 row_bcast:31 row_mask:0xc bank_mask:0xf
    s_nop 0
    v_readlane_b32 s46, v66, 63
    v_sub_f32 v68, v56, v64
    v_sub_f32 v69, v57, v64
    v_sub_f32 v70, v58, v64
    v_sub_f32 v71, v59, v64
    v_sub_f32 v72, v60, v64
    v_sub_f32 v73, v61, v64
    v_sub_f32 v74, v62, v64
    v_sub_f32 v75, v63, v64
    v_mul_f32 v66, s46, v65
    v_cvt_pk_bf16_f32 v66, v66, v66
    v_lshlrev_b32 v66, 16, v66
    v_add_f32 v66, 0x3727c5ac, v66
    v_cvt_pk_bf16_f32 v66, v66, v66
    v_lshlrev_b32 v66, 16, v66
    v_sqrt_f32 v66, v66
    v_cvt_pk_bf16_f32 v52, v68, v69
    v_cvt_pk_bf16_f32 v53, v70, v71
    v_cvt_pk_bf16_f32 v54, v72, v73
    v_cvt_pk_bf16_f32 v55, v74, v75
    v_cvt_pk_bf16_f32 v66, v66, v66
    v_lshlrev_b32 v66, 16, v66
    v_rcp_f32 v66, v66
    v_lshlrev_b32 v68, 16, v52
    v_and_b32 v69, 0xffff0000, v52
    v_lshlrev_b32 v70, 16, v53
    v_and_b32 v71, 0xffff0000, v53
    v_lshlrev_b32 v72, 16, v54
    v_and_b32 v73, 0xffff0000, v54
    v_lshlrev_b32 v74, 16, v55
    v_and_b32 v75, 0xffff0000, v55
    v_mul_f32 v68, v68, v66
    v_mul_f32 v69, v69, v66
    v_mul_f32 v70, v70, v66
    v_mul_f32 v71, v71, v66
    v_mul_f32 v72, v72, v66
    v_mul_f32 v73, v73, v66
    v_mul_f32 v74, v74, v66
    v_mul_f32 v75, v75, v66
    v_cvt_pk_bf16_f32 v52, v68, v69
    v_cvt_pk_bf16_f32 v53, v70, v71
    v_cvt_pk_bf16_f32 v54, v72, v73
    v_cvt_pk_bf16_f32 v55, v74, v75
    ds_write_b128 v20, v[52:55]
    s_waitcnt vmcnt(0)
    s_mov_b64 exec, 1
    ds_add_u32 v4, v5 offset:0
    s_mov_b64 exec, -1
    s_cmp_ge_u32 s32, 4
    s_cbranch_scc1 L_setup
spin_8:
    ds_read_b32 v7, v4 offset:0
    s_waitcnt lgkmcnt(0)
    v_readfirstlane_b32 s46, v7
    s_nop 0
    s_cmp_ge_u32 s46, 8
    s_cbranch_scc1 done_9
    s_sub_u32 s37, s37, 1
    s_cbranch_scc0 spin_8
    s_branch L_exit
done_9:
    ds_read2_b64 v[68:71], v11 offset0:0 offset1:4
    ds_read2_b64 v[72:75], v11 offset0:8 offset1:12
    ds_read2_b64 v[76:79], v11 offset0:16 offset1:20
    ds_read2_b64 v[80:83], v11 offset0:24 offset1:28
    ds_read_b64_tr_b16 v[52:53], v138 offset:0
    ds_read_b64_tr_b16 v[54:55], v138 offset:2048
    ds_read_b64_tr_b16 v[56:57], v138 offset:4096
    ds_read_b64_tr_b16 v[58:59], v138 offset:6144
    ds_read_b64_tr_b16 v[60:61], v138 offset:8192
    ds_read_b64_tr_b16 v[62:63], v138 offset:10240
    ds_read_b64_tr_b16 v[64:65], v138 offset:12288
    ds_read_b64_tr_b16 v[66:67], v138 offset:14336
    s_waitcnt lgkmcnt(6)
    v_mfma_f32_16x16x32_bf16 v[84:87], v[52:55], v[68:71], 0
    s_waitcnt lgkmcnt(4)
    v_mfma_f32_16x16x32_bf16 v[84:87], v[56:59], v[72:75], v[84:87]
    s_waitcnt lgkmcnt(2)
    v_mfma_f32_16x16x32_bf16 v[84:87], v[60:63], v[76:79], v[84:87]
    s_waitcnt lgkmcnt(0)
    v_mfma_f32_16x16x32_bf16 v[84:87], v[64:67], v[80:83], v[84:87]
    s_nop 7
    v_and_or_b32 v84, v84, s45, v3
    v_and_or_b32 v85, v85, s45, v3
    v_and_or_b32 v86, v86, s45, v3
    v_and_or_b32 v87, v87, s45, v3
    s_mov_b32 exec_lo, 0x00ff00ff
    s_mov_b32 exec_hi, 0x00ff00ff
    global_store_dwordx4 v24, v[84:87], s[28:29]
    s_mov_b64 exec, 1
    ds_add_u32 v4, v5 offset:16
    s_mov_b64 exec, -1
L_setup:
    s_lshl_b32 s46, s32, 3
    v_lshlrev_b32 v11, 1, v17
    v_add_u32 v11, s46, v11
    v_lshl_add_u32 v8, v13, 10, v11
    v_and_b32 v19, 31, v0
    v_lshlrev_b32 v10, 1, v19
    s_lshl_b32 s46, s33, 10
    v_add_u32 v122, s46, v10
    s_mul_i32 s46, s33, 16400
    s_add_u32 s46, s46, 65536
    v_bfe_u32 v11, v0, 2, 2
    v_lshlrev_b32 v11, 8, v11
    v_lshl_add_u32 v11, v18, 7, v11
    v_lshl_add_u32 v11, v15, 2, v11
    v_add_u32 v121, s46, v11
    s_lshr_b32 s47, s32, 2
    s_lshl_b32 s46, s33, 14
    s_lshl_b32 s51, s55, 8
    s_add_u32 s46, s46, s51
    s_lshl_b32 s51, s47, 7
    s_add_u32 s46, s46, s51
    s_add_u32 s46, s46, 65536
    v_lshlrev_b32 v11, 2, v17
    v_lshl_add_u32 v11, v13, 4, v11
    v_add_u32 v116, s46, v11
    s_lshr_b32 s46, s33, 1
    s_mul_i32 s52, s46, 28
    s_and_b32 s46, s33, 1
    s_lshl_b32 s46, s46, 4
    s_add_u32 s52, s52, s46
    s_lshr_b32 s46, s46, 2
    s_sub_u32 s60, 32, s46
    s_lshl_b32 s46, s52, 5
    v_lshlrev_b32 v11, 2, v14
    v_lshl_add_u32 v11, v2, 3, v11
    v_add_u32 v9, s46, v11
    v_lshlrev_b32 v21, 4, v0
    v_lshlrev_b32 v11, 4, v19
    v_add_u32 v120, 65536, v11
    s_lshl_b32 s46, s47, 9
    s_lshl_b32 s51, s55, 2
    s_add_u32 s46, s46, s51
    s_add_u32 s46, s46, 65536
    v_lshl_add_u32 v11, v14, 2, v17
    v_lshl_add_u32 v11, v15, 3, v11
    v_lshlrev_b32 v11, 4, v11
    v_add_u32 v119, s46, v11
    s_lshr_b32 s50, s32, 1
    s_and_b32 s47, s32, 1
    s_lshl_b32 s46, s33, 16
    s_lshl_b32 s51, s50, 12
    s_add_u32 s46, s46, s51
    s_lshl_b32 s51, s36, 10
    s_add_u32 s46, s46, s51
    s_lshl_b32 s51, s35, 7
    s_add_u32 s46, s46, s51
    s_lshl_b32 s51, s47, 6
    s_add_u32 s46, s46, s51
    s_add_u32 s46, s46, 1048576
    v_lshlrev_b32 v11, 14, v2
    v_lshl_add_u32 v11, v1, 2, v11
    v_add_u32 v108, s46, v11
    s_lshr_b32 s47, s32, 2
    s_lshl_b32 s46, s33, 11
    s_lshl_b32 s51, s34, 4
    s_add_u32 s46, s46, s51
    s_add_u32 s46, s46, 16384
    v_lshlrev_b32 v11, 9, v15
    v_add_u32 v123, s46, v11
    v_lshl_add_u32 v11, v2, 2, v16
    s_lshl_b32 s63, s55, 13
    v_lshlrev_b32 v11, 5, v11
    v_lshl_add_u32 v11, v15, 3, v11
    v_add_u32 v126, s63, v11
    v_lshl_add_u32 v11, v2, 2, v16
    v_and_b32 v12, 7, v11
    v_lshlrev_b32 v11, 8, v11
    v_lshl_add_u32 v11, v15, 3, v11
    v_lshl_add_u32 v19, v12, 5, v11
    v_add_u32 v127, s63, v19
    v_xor_b32 v12, s32, v12
    v_lshl_add_u32 v11, v12, 5, v11
    v_add_u32 v109, 0, v11
    s_mov_b32 s50, s47
    s_lshl_b32 s46, s33, 16
    s_lshl_b32 s51, s50, 14
    s_add_u32 s46, s46, s51
    s_lshl_b32 s51, s55, 12
    s_add_u32 s46, s46, s51
    s_add_u32 s46, s46, 1048576
    v_lshrrev_b32 v12, 3, v0
    v_add_u32 v110, s46, v21
    s_lshl_b32 s46, s33, 11
    s_lshl_b32 s51, s50, 9
    s_add_u32 s46, s46, s51
    s_add_u32 s46, s46, 16384
    v_lshlrev_b32 v11, 6, v12
    v_lshl_add_u32 v11, v15, 4, v11
    v_add_u32 v111, s46, v11
    s_lshl_b32 s46, s32, 9
    s_add_u32 s46, s46, 147456
    v_lshlrev_b32 v11, 7, v15
    v_lshl_add_u32 v11, v12, 4, v11
    v_and_b32 v12, 1, v16
    v_lshl_add_u32 v11, v12, 3, v11
    v_add_u32 v112, s46, v11
    v_lshlrev_b32 v11, 4, v13
    v_lshl_add_u32 v11, v2, 7, v11
    v_add_u32 v113, 147456, v11
    s_lshl_b32 s46, s55, 13
    s_lshl_b32 s51, s33, 8
    s_add_u32 s46, s46, s51
    s_add_u32 s46, s46, 262144
    v_lshlrev_b32 v11, 11, v2
    v_lshl_add_u32 v11, v13, 4, v11
    v_add_u32 v114, s46, v11
    s_lshl_b32 s46, s32, 11
    s_add_u32 s46, s46, 262144
    v_add_u32 v115, s46, v21
    s_min_u32 s48, s32, 6
    s_mul_i32 s46, s33, 114688
    s_lshl_b32 s51, s48, 11
    s_add_u32 s46, s46, s51
    s_add_u32 s46, s46, 2097152
    v_lshrrev_b32 v11, 2, v0
    v_lshlrev_b32 v11, 7, v11
    v_lshl_add_u32 v11, v15, 4, v11
    v_add_u32 v118, s46, v11
    v_add_u32 v134, 131072, v21
    s_lshr_b32 s46, s55, 1
    s_lshl_b32 s46, s46, 10
    s_and_b32 s47, s32, 1
    s_lshl_b32 s47, s47, 3
    s_add_u32 s46, s46, s47
    v_add_u32 v133, s46, v134
    v_lshlrev_b32 v11, 5, v13
    v_add_u32 v136, 135168, v11
    v_lshrrev_b32 v12, 1, v2
    v_lshl_add_u32 v11, v12, 2, v136
    s_lshl_b32 s46, s55, 3
    v_add_u32 v135, s46, v11
    v_lshrrev_b32 v11, 1, v0
    v_mul_u32_u24 v11, 3584, v11
    v_and_b32 v12, 1, v0
    v_lshl_add_u32 v124, v12, 4, v11
    v_lshlrev_b32 v12, 1, v2
    v_xor_b32 v12, v12, v1
    v_lshlrev_b32 v12, 4, v12
    v_lshl_add_u32 v125, v2, 10, v12
    s_mul_i32 s61, s55, 458752
    s_lshl_b32 s51, s52, 5
    s_add_u32 s61, s61, s51
    s_lshl_b32 s62, s52, 14
    s_lshl_b32 s51, s55, 8
    s_add_u32 s62, s62, s51
    s_lshl_b32 s46, s33, 14
    s_lshl_b32 s51, s55, 12
    s_add_u32 s46, s46, s51
    s_add_u32 s46, s46, 65536
    v_add_u32 v128, s46, v21
    s_mul_i32 s46, s55, 28672
    s_lshl_b32 s51, s52, 7
    s_add_u32 s46, s46, s51
    s_add_u32 s46, s46, 2097152
    v_lshrrev_b32 v12, 3, v0
    v_mul_u32_u24 v11, 114688, v12
    v_lshl_add_u32 v11, v13, 4, v11
    v_add_u32 v129, s46, v11
    v_add_u32 v130, 14336, v129
    v_mul_u32_u24 v11, 272, v12
    v_lshl_add_u32 v11, v13, 4, v11
    v_add_u32 v137, s63, v11
    v_lshl_add_u32 v12, v14, 2, v2
    v_mul_u32_u24 v11, 272, v13
    v_lshl_add_u32 v11, v12, 3, v11
    v_add_u32 v117, s63, v11
    s_bfe_u32 s46, s31, 65536
    s_bfe_u32 s47, s31, 65537
    s_lshl_b32 s47, s47, 16
    s_or_b32 s8, s46, s47
    s_bfe_u32 s46, s31, 65538
    s_bfe_u32 s47, s31, 65539
    s_lshl_b32 s47, s47, 16
    s_or_b32 s9, s46, s47
    s_bfe_u32 s46, s31, 65540
    s_bfe_u32 s47, s31, 65541
    s_lshl_b32 s47, s47, 16
    s_or_b32 s10, s46, s47
    s_bfe_u32 s46, s31, 65542
    s_bfe_u32 s47, s31, 65543
    s_lshl_b32 s47, s47, 16
    s_or_b32 s11, s46, s47
    v_cmp_eq_u32 vcc, 0, v18
    v_mov_b32 v11, s8
    v_mov_b32 v12, s10
    v_cndmask_b32 v131, v12, v11, vcc
    v_mov_b32 v11, s9
    v_mov_b32 v12, s11
    v_cndmask_b32 v132, v12, v11, vcc
    v_mov_b32 v140, 0x3f803f80
    v_mov_b32 v144, 0
    v_mov_b32 v141, 0x3f803f80
    v_mov_b32 v145, 0
    v_mov_b32 v142, 0x3f803f80
    v_mov_b32 v146, 0
    v_mov_b32 v143, 0x3f803f80
    v_mov_b32 v147, 0
    s_mov_b32 s40, s16
    s_mov_b32 s41, s17
    s_mov_b32 s42, 1835008
    s_mov_b32 s43, 0x20000
    s_mov_b32 s14, 4194304
    s_mov_b32 s15, 0x20000
    s_lshl_b32 s0, s33, 19
    s_lshl_b32 s51, s32, 15
    s_add_u32 s0, s0, s51
    s_and_b32 s46, s36, 1
    s_lshl_b32 s54, s35, 1
    s_add_u32 s54, s54, s46
    s_lshr_b32 s46, s36, 1
    s_lshl_b32 s46, s46, 4
    s_add_u32 s54, s54, s46
    s_and_b32 s39, s54, 15
    s_lshr_b32 s53, s39, 1
    s_xor_b32 s53, s53, 0
    s_and_b32 s44, s54, 1
    s_lshl_b32 s46, s44, 18
    s_add_u32 s0, s0, s46
    s_lshl_b32 s46, s53, 7
    s_add_u32 s0, s0, s46
    s_mov_b32 s6, s63
    s_lshl_b32 s46, s39, 5
    s_add_u32 s61, s61, s46
    s_lshl_b32 s1, s32, 13
    s_mov_b32 s56, s20
    s_mov_b32 s57, s21
    s_mov_b32 s58, 1835008
    s_mov_b32 s59, 0x20000
    s_mov_b32 s16, 0xffff0000
    s_mov_b32 s17, 0xffff0000
    s_mov_b32 s20, 0
    s_mov_b32 s21, -1
    s_cmp_eq_u32 s32, 7
    s_cbranch_scc1 L_xcc
    s_and_b32 s46, s32, 6
    s_cmp_eq_u32 s46, 4
    s_cbranch_scc1 L_qget
    s_cmp_lt_u32 s32, 4
    s_cbranch_scc1 L_qfix
    s_branch L_kwait
L_qget:
spin_10:
    ds_read_b32 v7, v4 offset:16
    s_waitcnt lgkmcnt(0)
    v_readfirstlane_b32 s46, v7
    s_nop 0
    s_cmp_ge_u32 s46, 4
    s_cbranch_scc1 done_11
    s_sub_u32 s37, s37, 1
    s_cbranch_scc0 spin_10
    s_branch L_exit
done_11:
    s_sleep 10
    s_mul_i32 s46, s55, 640
    s_add_u32 s46, s46, 155776
    v_lshrrev_b32 v11, 5, v0
    v_mul_u32_u24 v11, 320, v11
    v_and_b32 v12, 31, v0
    v_lshl_add_u32 v11, v12, 3, v11
    v_add_u32 v11, s46, v11
    global_load_dwordx4 v[84:87], v25, s[28:29] offset:-4096 sc1 nt
    global_load_dwordx4 v[88:91], v25, s[28:29] offset:0 sc1 nt
    global_load_dwordx4 v[92:95], v26, s[28:29] offset:-4096 sc1 nt
    global_load_dwordx4 v[96:99], v26, s[28:29] offset:0 sc1 nt
chk_12:
    s_waitcnt vmcnt(3)
    v_bitop3_b32 v149, v84, v85, s31 bitop3:0x7e
    v_bitop3_b32 v150, v86, v87, s31 bitop3:0x7e
    v_or3_b32 v12, v149, v150, v149
    s_waitcnt vmcnt(2)
    v_bitop3_b32 v149, v88, v89, s31 bitop3:0x7e
    v_bitop3_b32 v150, v90, v91, s31 bitop3:0x7e
    v_or3_b32 v12, v149, v150, v12
    s_waitcnt vmcnt(1)
    v_bitop3_b32 v149, v92, v93, s31 bitop3:0x7e
    v_bitop3_b32 v150, v94, v95, s31 bitop3:0x7e
    v_or3_b32 v12, v149, v150, v12
    s_waitcnt vmcnt(0)
    v_bitop3_b32 v149, v96, v97, s31 bitop3:0x7e
    v_bitop3_b32 v150, v98, v99, s31 bitop3:0x7e
    v_or3_b32 v12, v149, v150, v12
    v_cmp_ne_u32_sdwa vcc, v12, v148 src0_sel:BYTE_0 src1_sel:DWORD
    s_cbranch_vccz ok_13
    s_mov_b64 exec, vcc
    global_load_dwordx4 v[84:87], v25, s[28:29] offset:-4096 sc1 nt
    global_load_dwordx4 v[88:91], v25, s[28:29] offset:0 sc1 nt
    global_load_dwordx4 v[92:95], v26, s[28:29] offset:-4096 sc1 nt
    global_load_dwordx4 v[96:99], v26, s[28:29] offset:0 sc1 nt
    s_sub_u32 s37, s37, 1
    s_cbranch_scc0 chk_12
    s_branch L_exit
ok_13:
    s_mov_b64 exec, -1
    v_add_f32 v84, v84, v88
    v_add_f32 v92, v92, v96
    v_add_f32 v85, v85, v89
    v_add_f32 v93, v93, v97
    v_add_f32 v86, v86, v90
    v_add_f32 v94, v94, v98
    v_add_f32 v87, v87, v91
    v_add_f32 v95, v95, v99
    v_add_f32 v84, v84, v92
    v_add_f32 v85, v85, v93
    v_add_f32 v86, v86, v94
    v_add_f32 v87, v87, v95
    v_cvt_pk_bf16_f32 v84, v84, v85
    v_cvt_pk_bf16_f32 v85, v86, v87
    ds_write_b64 v11, v[84:85]
    s_mov_b64 exec, 1
    ds_add_u32 v4, v5 offset:12
    s_mov_b64 exec, -1
    s_branch L_kwait
L_qfix:
spin_14:
    ds_read_b32 v7, v4 offset:28
    s_waitcnt lgkmcnt(0)
    v_readfirstlane_b32 s46, v7
    s_nop 0
    s_cmp_ge_u32 s46, 1
    s_cbranch_scc1 done_15
    s_sleep 1
    s_sub_u32 s37, s37, 1
    s_cbranch_scc0 spin_14
    s_branch L_exit
done_15:
    s_cmp_eq_u32 s46, 1
    s_cbranch_scc1 L_kwait
    s_mov_b32 exec_lo, 0x00ff00ff
    s_mov_b32 exec_hi, 0x00ff00ff
    global_store_dwordx4 v24, v[84:87], s[28:29] sc1
    s_mov_b64 exec, -1
    s_branch L_kwait
L_xcc:
    s_lshl_b32 s46, s33, 12
    s_add_u32 s46, s46, 32768
    v_and_b32 v19, 31, v0
    v_lshlrev_b32 v19, 7, v19
    v_add_u32 v19, s46, v19
    s_getreg_b32 s47, hwreg(HW_REG_XCC_ID)
    s_lshl_b32 s47, s47, 8
    s_or_b32 s38, s47, s31
spin_16:
    ds_read_b32 v7, v4 offset:16
    s_waitcnt lgkmcnt(0)
    v_readfirstlane_b32 s46, v7
    s_nop 0
    s_cmp_ge_u32 s46, 4
    s_cbranch_scc1 done_17
    s_sub_u32 s37, s37, 1
    s_cbranch_scc0 spin_16
    s_branch L_exit
done_17:
    global_load_dwordx4 v[84:87], v19, s[28:29] sc1 nt
chk_18:
    s_waitcnt vmcnt(0)
    v_bitop3_b32 v149, v84, v85, s31 bitop3:0x7e
    v_bitop3_b32 v150, v86, v87, s31 bitop3:0x7e
    v_or3_b32 v12, v149, v150, v149
    v_cmp_ne_u32_sdwa vcc, v12, v148 src0_sel:BYTE_0 src1_sel:DWORD
    s_cbranch_vccz ok_19
    s_mov_b64 exec, vcc
    global_load_dwordx4 v[84:87], v19, s[28:29] sc1 nt
    s_sub_u32 s37, s37, 1
    s_cbranch_scc0 chk_18
    s_branch L_exit
ok_19:
    s_mov_b64 exec, -1
    v_cmp_ne_u32 vcc, s38, v84
    s_nop 0
    s_cmp_eq_u64 vcc, 0
    s_cselect_b32 s46, 1, 2
    v_mov_b32 v12, s46
    ds_write_b32 v4, v12 offset:28
L_kwait:
    s_lshl_b32 s46, s32, 13
    v_xor_b32 v11, v2, v1
    v_lshlrev_b32 v11, 4, v11
    v_lshl_add_u32 v11, v1, 8, v11
    v_add_u32 v100, s46, v11
    v_xor_b32 v101, 64, v100
    v_xor_b32 v102, 0x80, v100
    v_xor_b32 v103, 0xc0, v100
    v_mul_u32_u24 v18, 320, v15
    v_lshl_add_u32 v18, v2, 4, v18
    v_add_u32 v18, 155776, v18
    s_lshl_b32 s47, s32, 2
    v_lshl_add_u32 v11, v15, 2, v2
    v_lshlrev_b32 v11, 5, v11
    v_add_u32 v12, 159104, v11
    v_add_u32 v11, s47, v12
    v_lshlrev_b32 v13, 4, v15
    v_lshl_add_u32 v13, v2, 6, v13
    v_add_u32 v13, 157056, v13
    s_lshl_b32 s47, s33, 1
    s_add_u32 s47, s47, s34
    s_bfe_u32 s48, s47, 0x30001
    s_sub_u32 s47, s32, s48
    s_and_b32 s47, s47, 7
    s_lshl_b32 s48, s48, 13
    s_lshl_b32 s47, s47, 8
    v_add_u32 v14, s47, v13
    v_add_u32 v16, s48, v109
    v_add_u32 v92, 0, v16
    v_or_b32 v92, 65536, v92
    v_add_u32 v93, 8192, v16
    v_or_b32 v93, 65536, v93
    v_add_u32 v94, 16384, v16
    v_or_b32 v94, 65536, v94
    v_add_u32 v95, 24576, v16
    v_or_b32 v95, 65536, v95
    v_add_u32 v96, 32768, v16
    v_or_b32 v96, 65536, v96
    v_add_u32 v97, 40960, v16
    v_or_b32 v97, 65536, v97
    v_add_u32 v98, 49152, v16
    v_or_b32 v98, 65536, v98
    v_add_u32 v99, 57344, v16
    v_or_b32 v99, 65536, v99
    s_mov_b32 s48, 0x3db504f3
    s_mov_b32 s49, 0x3db504f3
    s_mov_b32 s47, 0x3fb8aa3b
spin_20:
    ds_read_b32 v7, v4 offset:12
    s_waitcnt lgkmcnt(0)
    v_readfirstlane_b32 s46, v7
    s_nop 0
    s_cmp_ge_u32 s46, 2
    s_cbranch_scc1 done_21
    s_sub_u32 s37, s37, 1
    s_cbranch_scc0 spin_20
    s_branch L_exit
done_21:
    ds_read_b128 v[52:55], v18 offset:0
    ds_read_b128 v[56:59], v18 offset:64
    ds_read_b128 v[60:63], v18 offset:128
    ds_read_b128 v[64:67], v18 offset:192
spin_22:
    ds_read_b32 v7, v4 offset:24
    s_waitcnt lgkmcnt(0)
    v_readfirstlane_b32 s46, v7
    s_nop 0
    s_cmp_ge_u32 s46, 1
    s_cbranch_scc1 done_23
    s_sub_u32 s37, s37, 1
    s_cbranch_scc0 spin_22
    s_branch L_exit
done_23:
    ds_read_b128 v[20:23], v100 offset:0
    ds_read_b128 v[36:39], v100 offset:4096
    ds_read_b128 v[24:27], v101 offset:0
    ds_read_b128 v[40:43], v101 offset:4096
    ds_read_b128 v[28:31], v102 offset:0
    ds_read_b128 v[44:47], v102 offset:4096
    ds_read_b128 v[32:35], v103 offset:0
    ds_read_b128 v[48:51], v103 offset:4096
    s_waitcnt lgkmcnt(7)
    v_mfma_f32_16x16x32_bf16 v[68:71], v[20:23], v[52:55], 0
    s_waitcnt lgkmcnt(6)
    v_mfma_f32_16x16x32_bf16 v[72:75], v[36:39], v[52:55], 0
    s_waitcnt lgkmcnt(5)
    v_mfma_f32_16x16x32_bf16 v[68:71], v[24:27], v[56:59], v[68:71]
    s_waitcnt lgkmcnt(4)
    v_mfma_f32_16x16x32_bf16 v[72:75], v[40:43], v[56:59], v[72:75]
    s_waitcnt lgkmcnt(3)
    v_mfma_f32_16x16x32_bf16 v[68:71], v[28:31], v[60:63], v[68:71]
    s_waitcnt lgkmcnt(2)
    v_mfma_f32_16x16x32_bf16 v[72:75], v[44:47], v[60:63], v[72:75]
    s_waitcnt lgkmcnt(1)
    v_mfma_f32_16x16x32_bf16 v[68:71], v[32:35], v[64:67], v[68:71]
    s_waitcnt lgkmcnt(0)
    v_mfma_f32_16x16x32_bf16 v[72:75], v[48:51], v[64:67], v[72:75]
    s_and_b32 s46, s34, 0x1e
    s_cmp_lg_u32 s46, 12
    s_cbranch_scc1 ntr_24
    s_mov_b32 m0, s1
    s_add_u32 s1, s1, 1024
    buffer_load_dwordx4 v139, s[12:15], s0 offen nt lds
    s_add_u32 s0, s0, 8192
ntr_24:
    s_nop 2
    v_cvt_pk_bf16_f32 v76, v68, v69
    v_cvt_pk_bf16_f32 v77, v70, v71
    v_lshlrev_b32 v68, 16, v76
    v_and_b32 v69, 0xffff0000, v76
    v_lshlrev_b32 v70, 16, v77
    v_and_b32 v71, 0xffff0000, v77
    v_pk_mul_f32 v[68:69], v[68:69], s[48:49]
    v_pk_mul_f32 v[70:71], v[70:71], s[48:49]
    v_cvt_pk_bf16_f32 v76, v68, v69
    v_cvt_pk_bf16_f32 v77, v70, v71
    v_lshlrev_b32 v68, 16, v76
    v_and_b32 v69, 0xffff0000, v76
    v_lshlrev_b32 v70, 16, v77
    v_and_b32 v71, 0xffff0000, v77
    v_cvt_pk_bf16_f32 v78, v72, v73
    v_cvt_pk_bf16_f32 v79, v74, v75
    v_lshlrev_b32 v72, 16, v78
    v_and_b32 v73, 0xffff0000, v78
    v_lshlrev_b32 v74, 16, v79
    v_and_b32 v75, 0xffff0000, v79
    v_pk_mul_f32 v[72:73], v[72:73], s[48:49]
    v_pk_mul_f32 v[74:75], v[74:75], s[48:49]
    v_cvt_pk_bf16_f32 v78, v72, v73
    v_cvt_pk_bf16_f32 v79, v74, v75
    v_lshlrev_b32 v72, 16, v78
    v_and_b32 v73, 0xffff0000, v78
    v_lshlrev_b32 v74, 16, v79
    v_and_b32 v75, 0xffff0000, v79
    v_max3_f32 v76, v68, v69, v70
    v_max3_f32 v77, v72, v73, v74
    v_max3_f32 v76, v71, v75, v76
    v_max_f32 v76, v76, v77
    ds_write_b32 v11, v76
    s_mov_b64 exec, 1
    ds_add_u32 v4, v5 offset:4
    s_mov_b64 exec, -1
spin_25:
    ds_read_b32 v7, v4 offset:4
    s_waitcnt lgkmcnt(0)
    v_readfirstlane_b32 s46, v7
    s_nop 0
    s_cmp_ge_u32 s46, 8
    s_cbranch_scc1 done_26
    s_sub_u32 s37, s37, 1
    s_cbranch_scc0 spin_25
    s_branch L_exit
done_26:
    s_and_b32 s46, s34, 0x1e
    s_cmp_lg_u32 s46, 12
    s_cbranch_scc1 ntr_27
    s_mov_b32 m0, s1
    s_add_u32 s1, s1, 1024
    buffer_load_dwordx4 v139, s[12:15], s0 offen nt lds
    s_add_u32 s0, s0, 8192
ntr_27:
    ds_read_b128 v[76:79], v12
    ds_read_b128 v[80:83], v12 offset:16
    s_waitcnt lgkmcnt(0)
    v_max3_f32 v76, v76, v77, v78
    v_max3_f32 v80, v80, v81, v82
    v_max3_f32 v76, v76, v79, v83
    v_max_f32 v76, v76, v80
    v_mov_b32 v77, v76
    s_nop 1
    v_permlane16_swap_b32 v76, v77
    v_max_f32 v76, v76, v77
    v_mov_b32 v77, v76
    s_nop 1
    v_permlane32_swap_b32 v76, v77
    v_max_f32 v76, v76, v77
    v_mul_f32 v84, s47, v76
    v_fma_f32 v68, v68, s47, -v84
    v_fma_f32 v69, v69, s47, -v84
    v_fma_f32 v70, v70, s47, -v84
    v_fma_f32 v71, v71, s47, -v84
    v_fma_f32 v72, v72, s47, -v84
    v_fma_f32 v73, v73, s47, -v84
    v_fma_f32 v74, v74, s47, -v84
    v_fma_f32 v75, v75, s47, -v84
    v_exp_f32 v68, v68
    v_exp_f32 v69, v69
    v_exp_f32 v70, v70
    v_exp_f32 v71, v71
    v_exp_f32 v72, v72
    v_exp_f32 v73, v73
    v_exp_f32 v74, v74
    v_exp_f32 v75, v75
    v_cvt_pk_bf16_f32 v76, v68, v69
    v_cvt_pk_bf16_f32 v77, v70, v71
    v_cvt_pk_bf16_f32 v78, v72, v73
    v_cvt_pk_bf16_f32 v79, v74, v75
    ds_write_b128 v14, v[76:79]
    v_pk_add_f32 v[68:69], v[68:69], v[70:71]
    v_pk_add_f32 v[72:73], v[72:73], v[74:75]
    v_pk_add_f32 v[68:69], v[68:69], v[72:73]
    v_add_f32 v68, v68, v69
    ds_write_b32 v11, v68 offset:512
    s_mov_b64 exec, 1
    ds_add_u32 v4, v5 offset:8
    s_mov_b64 exec, -1
spin_28:
    ds_read_b32 v7, v4 offset:28
    s_waitcnt lgkmcnt(0)
    v_readfirstlane_b32 s46, v7
    s_nop 0
    s_cmp_ge_u32 s46, 1
    s_cbranch_scc1 done_29
    s_sub_u32 s37, s37, 1
    s_cbranch_scc0 spin_28
    s_branch L_exit
done_29:
    s_mov_b32 s38, s46
spin_30:
    ds_read_b32 v7, v4 offset:8
    s_waitcnt lgkmcnt(0)
    v_readfirstlane_b32 s46, v7
    s_nop 0
    s_cmp_ge_u32 s46, 8
    s_cbranch_scc1 done_31
    s_sub_u32 s37, s37, 1
    s_cbranch_scc0 spin_30
    s_branch L_exit
done_31:
    ds_read_b128 v[76:79], v12 offset:512
    ds_read_b128 v[80:83], v12 offset:528
    ds_read_b128 v[20:23], v13 offset:0
    ds_read_b128 v[24:27], v13 offset:256
    ds_read_b128 v[28:31], v13 offset:512
    ds_read_b128 v[32:35], v13 offset:768
    ds_read_b128 v[36:39], v13 offset:1024
    ds_read_b128 v[40:43], v13 offset:1280
    ds_read_b128 v[44:47], v13 offset:1536
    ds_read_b128 v[48:51], v13 offset:1792
    s_waitcnt lgkmcnt(8)
    v_pk_add_f32 v[76:77], v[76:77], v[78:79]
    v_pk_add_f32 v[80:81], v[80:81], v[82:83]
    v_pk_add_f32 v[76:77], v[76:77], v[80:81]
    v_add_f32 v76, v76, v77
    v_mov_b32 v77, v76
    s_nop 1
    v_permlane16_swap_b32 v76, v77
    v_add_f32 v76, v76, v77
    v_mov_b32 v77, v76
    s_nop 1
    v_permlane32_swap_b32 v76, v77
    v_add_f32 v76, v76, v77
    v_log_f32 v77, v76
    v_rcp_f32 v86, v76
    v_add_f32 v84, v84, v77
    s_nop 0
    v_mov_b32_dpp v85, v86 quad_perm:[0,0,0,0] row_mask:1 bank_mask:0xf
    s_nop 1
    v_mov_b32_dpp v85, v86 quad_perm:[1,1,1,1] row_mask:2 bank_mask:0xf
    s_nop 1
    v_mov_b32_dpp v85, v86 quad_perm:[2,2,2,2] row_mask:4 bank_mask:0xf
    s_nop 1
    v_mov_b32_dpp v85, v86 quad_perm:[3,3,3,3] row_mask:8 bank_mask:0xf
    s_cmp_lg_u32 s32, 0
    s_cbranch_scc1 L_nolse
    v_and_or_b32 v88, v84, s45, v3
    v_mov_b32 v89, v88
    v_mov_b32 v90, v88
    v_mov_b32 v91, v88
    s_mov_b64 exec, 15
    s_cmp_lg_u32 s38, 1
    s_cbranch_scc1 slow_32
    global_store_dwordx4 v123, v[88:91], s[28:29]
back_33:
    s_mov_b64 exec, -1
L_nolse:
    s_waitcnt lgkmcnt(0)
    s_cmp_ge_u32 s54, 16
    s_cbranch_scc1 L_nowo
spin_34:
    ds_read_b32 v7, v4 offset:32
    s_waitcnt lgkmcnt(0)
    v_readfirstlane_b32 s46, v7
    s_nop 0
    s_cmp_ge_u32 s46, 1
    s_cbranch_scc1 done_35
    s_sub_u32 s37, s37, 1
    s_cbranch_scc0 spin_34
    s_branch L_exit
done_35:
    s_cmp_eq_u32 s35, 3
    s_cbranch_scc1 L_wolast
    s_mov_b32 m0, s1
    s_add_u32 s1, s1, 1024
    buffer_load_dwordx4 v139, s[12:15], s0 offen nt lds
    s_add_u32 s0, s0, 8192
    s_mov_b32 m0, s1
    s_add_u32 s1, s1, 1024
    buffer_load_dwordx4 v139, s[12:15], s0 offen nt lds
    s_add_u32 s0, s0, 8192
L_wolast:
    s_mov_b32 m0, s1
    s_add_u32 s1, s1, 1024
    buffer_load_dwordx4 v139, s[12:15], s0 offen nt lds
    s_add_u32 s0, s0, 8192
    s_mov_b32 m0, s1
    s_add_u32 s1, s1, 1024
    buffer_load_dwordx4 v139, s[12:15], s0 offen nt lds
    s_add_u32 s0, s0, 8192
L_nowo:
spin_36:
    ds_read_b32 v7, v4 offset:36
    s_waitcnt lgkmcnt(0)
    v_readfirstlane_b32 s46, v7
    s_nop 0
    s_cmp_ge_u32 s46, 1
    s_cbranch_scc1 done_37
    s_sub_u32 s37, s37, 1
    s_cbranch_scc0 spin_36
    s_branch L_exit
done_37:
    ds_read_b64_tr_b16 v[52:53], v92 offset:0
    ds_read_b64_tr_b16 v[54:55], v92 offset:4096
    ds_read_b64_tr_b16 v[56:57], v93 offset:0
    ds_read_b64_tr_b16 v[58:59], v93 offset:4096
    ds_read_b64_tr_b16 v[60:61], v94 offset:0
    ds_read_b64_tr_b16 v[62:63], v94 offset:4096
    ds_read_b64_tr_b16 v[64:65], v95 offset:0
    ds_read_b64_tr_b16 v[66:67], v95 offset:4096
    ds_read_b64_tr_b16 v[68:69], v96 offset:0
    ds_read_b64_tr_b16 v[70:71], v96 offset:4096
    ds_read_b64_tr_b16 v[72:73], v97 offset:0
    ds_read_b64_tr_b16 v[74:75], v97 offset:4096
    ds_read_b64_tr_b16 v[76:77], v98 offset:0
    ds_read_b64_tr_b16 v[78:79], v98 offset:4096
    s_waitcnt lgkmcnt(12)
    v_mfma_f32_16x16x32_bf16 v[88:91], v[20:23], v[52:55], 0
    s_waitcnt lgkmcnt(10)
    v_mfma_f32_16x16x32_bf16 v[88:91], v[24:27], v[56:59], v[88:91]
    s_waitcnt lgkmcnt(8)
    v_mfma_f32_16x16x32_bf16 v[88:91], v[28:31], v[60:63], v[88:91]
    s_waitcnt lgkmcnt(6)
    v_mfma_f32_16x16x32_bf16 v[88:91], v[32:35], v[64:67], v[88:91]
    s_waitcnt lgkmcnt(4)
    v_mfma_f32_16x16x32_bf16 v[88:91], v[36:39], v[68:71], v[88:91]
    s_waitcnt lgkmcnt(2)
    v_mfma_f32_16x16x32_bf16 v[88:91], v[40:43], v[72:75], v[88:91]
    s_waitcnt lgkmcnt(0)
    v_mfma_f32_16x16x32_bf16 v[88:91], v[44:47], v[76:79], v[88:91]
    s_barrier
    ds_read_b64_tr_b16 v[80:81], v99 offset:0
    ds_read_b64_tr_b16 v[82:83], v99 offset:4096
    s_waitcnt lgkmcnt(0)
    v_mfma_f32_16x16x32_bf16 v[88:91], v[48:51], v[80:83], v[88:91]
    s_cmp_lg_u32 s38, 1
    s_nop 6
    v_cndmask_b32 v88, v88, v89, s[16:17]
    v_cndmask_b32 v90, v90, v91, s[16:17]
    v_cndmask_b32 v88, v88, v90, s[20:21]
    v_mul_f32 v88, v88, v85
    v_and_or_b32 v88, v88, s45, v3
    s_cbranch_scc1 slow_38
    global_store_dword v108, v88, s[28:29]
back_39:
    s_cmp_ge_u32 s54, 16
    s_cbranch_scc1 L_notop
    s_lshl_b32 s46, s44, 10
    v_add_u32 v111, s46, v111
    s_lshl_b32 s46, s44, 15
    v_add_u32 v110, s46, v110
    global_load_dwordx4 v[84:87], v111, s[28:29] sc1
    s_lshl_b32 s46, s39, 6
    v_add_u32 v8, s46, v8
    v_add_u32 v10, s46, v10
    v_add_u32 v122, s46, v122
    s_lshl_b32 s46, s39, 10
    v_add_u32 v121, s46, v121
    v_add_u32 v116, s46, v116
    s_lshl_b32 s46, s39, 14
    v_add_u32 v115, s46, v115
    s_lshl_b32 s46, s53, 15
    s_lshl_b32 s51, s44, 7
    s_add_u32 s46, s46, s51
    v_add_u32 v114, s46, v114
    s_lshr_b32 s47, s39, 1
    s_mul_i32 s46, s47, 14336
    s_lshl_b32 s51, s44, 6
    s_add_u32 s46, s46, s51
    v_add_u32 v118, s46, v118
    s_waitcnt vmcnt(2)
    global_load_dwordx4 v[88:91], v110, s[28:29] offset:0 sc1
    global_load_dwordx4 v[92:95], v110, s[28:29] offset:1024 sc1
    global_load_dwordx4 v[96:99], v110, s[28:29] offset:2048 sc1
    global_load_dwordx4 v[100:103], v110, s[28:29] offset:3072 sc1
    s_waitcnt vmcnt(4)
    s_barrier
    s_cmp_ge_u32 s32, 4
    s_cbranch_scc1 L_opchk
    ds_read_b64_tr_b16 v[20:21], v6 offset:0
    ds_read_b64_tr_b16 v[22:23], v6 offset:2048
    ds_read_b64_tr_b16 v[24:25], v6 offset:8192
    ds_read_b64_tr_b16 v[26:27], v6 offset:10240
    ds_read_b64_tr_b16 v[28:29], v6 offset:16384
    ds_read_b64_tr_b16 v[30:31], v6 offset:18432
    ds_read_b64_tr_b16 v[32:33], v6 offset:24576
    ds_read_b64_tr_b16 v[34:35], v6 offset:26624
    ds_read_b64_tr_b16 v[36:37], v6 offset:32768
    ds_read_b64_tr_b16 v[38:39], v6 offset:34816
    ds_read_b64_tr_b16 v[40:41], v6 offset:40960
    ds_read_b64_tr_b16 v[42:43], v6 offset:43008
    ds_read_b64_tr_b16 v[44:45], v6 offset:49152
    ds_read_b64_tr_b16 v[46:47], v6 offset:51200
    ds_read_b64_tr_b16 v[48:49], v6 offset:57344
    ds_read_b64_tr_b16 v[50:51], v6 offset:59392
L_opchk:
chk_40:
    v_bitop3_b32 v149, v84, v85, s31 bitop3:0x7e
    v_bitop3_b32 v150, v86, v87, s31 bitop3:0x7e
    v_or3_b32 v16, v149, v150, v149
    v_cmp_ne_u32_sdwa vcc, v16, v148 src0_sel:BYTE_0 src1_sel:DWORD
    s_cbranch_vccz ok_41
    s_mov_b64 exec, vcc
    global_load_dwordx4 v[84:87], v111, s[28:29] sc1
    s_waitcnt vmcnt(0)
    s_sub_u32 s37, s37, 1
    s_cbranch_scc0 chk_40
    s_branch L_exit
ok_41:
    s_mov_b64 exec, -1
    v_max_f32_dpp v85, v84, v84 quad_perm:[1,0,3,2] row_mask:0xf bank_mask:0xf
    s_nop 1
    v_max_f32_dpp v85, v85, v85 quad_perm:[2,3,0,1] row_mask:0xf bank_mask:0xf
    v_sub_f32 v84, v84, v85
    v_exp_f32 v84, v84
    s_nop 1
    v_add_f32_dpp v85, v84, v84 quad_perm:[1,0,3,2] row_mask:0xf bank_mask:0xf
    s_nop 1
    v_add_f32_dpp v85, v85, v85 quad_perm:[2,3,0,1] row_mask:0xf bank_mask:0xf
    v_rcp_f32 v85, v85
    s_nop 0
    v_mul_f32 v84, v84, v85
    s_nop 1
    v_mov_b32_dpp v80, v84 quad_perm:[0,0,0,0] row_mask:0xf bank_mask:0xf
    v_mov_b32_dpp v81, v84 quad_perm:[1,1,1,1] row_mask:0xf bank_mask:0xf
    v_mov_b32_dpp v82, v84 quad_perm:[2,2,2,2] row_mask:0xf bank_mask:0xf
    v_mov_b32_dpp v83, v84 quad_perm:[3,3,3,3] row_mask:0xf bank_mask:0xf
chk_42:
    s_waitcnt vmcnt(3)
    v_bitop3_b32 v149, v88, v89, s31 bitop3:0x7e
    v_bitop3_b32 v150, v90, v91, s31 bitop3:0x7e
    v_or3_b32 v16, v149, v150, v149
    v_mul_f32 v104, v80, v88
    v_mul_f32 v105, v80, v89
    v_mul_f32 v106, v80, v90
    v_mul_f32 v107, v80, v91
    s_waitcnt vmcnt(2)
    v_bitop3_b32 v149, v92, v93, s31 bitop3:0x7e
    v_bitop3_b32 v150, v94, v95, s31 bitop3:0x7e
    v_or3_b32 v16, v149, v150, v16
    v_fmac_f32 v104, v81, v92
    v_fmac_f32 v105, v81, v93
    v_fmac_f32 v106, v81, v94
    v_fmac_f32 v107, v81, v95
    s_waitcnt vmcnt(1)
    v_bitop3_b32 v149, v96, v97, s31 bitop3:0x7e
    v_bitop3_b32 v150, v98, v99, s31 bitop3:0x7e
    v_or3_b32 v16, v149, v150, v16
    v_fmac_f32 v104, v82, v96
    v_fmac_f32 v105, v82, v97
    v_fmac_f32 v106, v82, v98
    v_fmac_f32 v107, v82, v99
    s_waitcnt vmcnt(0)
    v_bitop3_b32 v149, v100, v101, s31 bitop3:0x7e
    v_bitop3_b32 v150, v102, v103, s31 bitop3:0x7e
    v_or3_b32 v16, v149, v150, v16
    v_cmp_ne_u32_sdwa vcc, v16, v148 src0_sel:BYTE_0 src1_sel:DWORD
    s_cbranch_vccz ok_43
    s_mov_b64 exec, vcc
    s_sleep 1
    global_load_dwordx4 v[88:91], v110, s[28:29] offset:0 sc1
    global_load_dwordx4 v[92:95], v110, s[28:29] offset:1024 sc1
    global_load_dwordx4 v[96:99], v110, s[28:29] offset:2048 sc1
    global_load_dwordx4 v[100:103], v110, s[28:29] offset:3072 sc1
    s_sub_u32 s37, s37, 1
    s_cbranch_scc0 chk_42
    s_branch L_exit
ok_43:
    s_mov_b64 exec, -1
    v_fmac_f32 v104, v83, v100
    v_fmac_f32 v105, v83, v101
    v_fmac_f32 v106, v83, v102
    v_fmac_f32 v107, v83, v103
    v_cvt_pk_bf16_f32 v104, v104, v105
    v_cvt_pk_bf16_f32 v105, v106, v107
    ds_write_b64 v112, v[104:105]
    s_cmp_ge_u32 s32, 4
    s_waitcnt lgkmcnt(0)
    s_barrier
    s_cbranch_scc1 L_reduce
    ds_read_b128 v[52:55], v113 offset:0
    ds_read_b128 v[56:59], v113 offset:512
    ds_read_b128 v[60:63], v113 offset:1024
    ds_read_b128 v[64:67], v113 offset:1536
    ds_read_b128 v[68:71], v113 offset:2048
    ds_read_b128 v[72:75], v113 offset:2560
    ds_read_b128 v[76:79], v113 offset:3072
    ds_read_b128 v[80:83], v113 offset:3584
    s_waitcnt lgkmcnt(7)
    v_mfma_f32_16x16x32_bf16 v[84:87], v[20:23], v[52:55], 0
    s_waitcnt lgkmcnt(6)
    v_mfma_f32_16x16x32_bf16 v[84:87], v[24:27], v[56:59], v[84:87]
    s_waitcnt lgkmcnt(5)
    v_mfma_f32_16x16x32_bf16 v[84:87], v[28:31], v[60:63], v[84:87]
    s_waitcnt lgkmcnt(4)
    v_mfma_f32_16x16x32_bf16 v[84:87], v[32:35], v[64:67], v[84:87]
    s_waitcnt lgkmcnt(3)
    v_mfma_f32_16x16x32_bf16 v[84:87], v[36:39], v[68:71], v[84:87]
    s_waitcnt lgkmcnt(2)
    v_mfma_f32_16x16x32_bf16 v[84:87], v[40:43], v[72:75], v[84:87]
    s_waitcnt lgkmcnt(1)
    v_mfma_f32_16x16x32_bf16 v[84:87], v[44:47], v[76:79], v[84:87]
    s_waitcnt lgkmcnt(0)
    v_mfma_f32_16x16x32_bf16 v[84:87], v[48:51], v[80:83], v[84:87]
    s_mov_b32 exec_lo, 0x00ff00ff
    s_mov_b32 exec_hi, 0x00ff00ff
    s_nop 5
    v_and_or_b32 v84, v84, s45, v3
    v_and_or_b32 v85, v85, s45, v3
    v_and_or_b32 v86, v86, s45, v3
    v_and_or_b32 v87, v87, s45, v3
    global_store_dwordx4 v114, v[84:87], s[28:29] sc1
    s_mov_b64 exec, -1
L_reduce:
    s_barrier
    global_load_ushort v8, v8, s[4:5]
    global_load_ushort v10, v10, s[22:23]
    s_sleep 16
    global_load_dwordx4 v[52:55], v115, s[28:29] sc1
    global_load_dwordx4 v[56:59], v115, s[28:29] offset:1024 sc1
chk_44:
    s_waitcnt vmcnt(1)
    v_bitop3_b32 v149, v52, v53, s31 bitop3:0x7e
    v_bitop3_b32 v150, v54, v55, s31 bitop3:0x7e
    v_or3_b32 v12, v149, v150, v149
    s_waitcnt vmcnt(0)
    v_bitop3_b32 v149, v56, v57, s31 bitop3:0x7e
    v_bitop3_b32 v150, v58, v59, s31 bitop3:0x7e
    v_or3_b32 v12, v149, v150, v12
    v_cmp_ne_u32_sdwa vcc, v12, v148 src0_sel:BYTE_0 src1_sel:DWORD
    s_cbranch_vccz ok_45
    s_mov_b64 exec, vcc
    s_sleep 2
    global_load_dwordx4 v[52:55], v115, s[28:29] sc1
    global_load_dwordx4 v[56:59], v115, s[28:29] offset:1024 sc1
    s_sub_u32 s37, s37, 1
    s_cbranch_scc0 chk_44
    s_branch L_exit
ok_45:
    s_mov_b64 exec, -1
    v_add_f32 v52, v52, v56
    v_add_f32 v53, v53, v57
    v_add_f32 v54, v54, v58
    v_add_f32 v55, v55, v59
    v_permlane32_swap_b32 v52, v53
    v_lshlrev_b32 v8, 16, v8
    v_permlane32_swap_b32 v54, v55
    v_add_f32 v52, v52, v53
    v_add_f32 v54, v54, v55
    s_cmp_lg_u32 s38, 1
    s_nop 0
    v_permlane16_swap_b32 v52, v54
    v_add_f32 v52, v52, v54
    s_nop 1
    v_add_f32_dpp v52, v52, v52 row_ror:8 row_mask:0xf bank_mask:0xf
    v_cvt_pk_bf16_f32 v52, v52, v52
    v_lshlrev_b32 v52, 16, v52
    v_add_f32 v52, v52, v8
    v_cvt_pk_bf16_f32 v52, v52, v52
    v_lshl_or_b32 v52, v52, 16, v3
    s_cbranch_scc1 slow_46
    global_store_dword v116, v52, s[28:29]
back_47:
L_final:
    s_lshl_b32 s46, s33, 8
    s_add_u32 s46, s46, 4096
    v_lshlrev_b32 v10, 16, v10
    s_sub_u32 s47, s60, 17
    v_min_u32 v11, s47, v0
    v_lshlrev_b32 v11, 4, v11
    v_add_u32 v11, s46, v11
    v_mov_b32 v56, 0
    global_load_dwordx4 v[52:55], v11, s[28:29] sc1
chk_48:
    s_waitcnt vmcnt(0)
    v_bitop3_b32 v149, v52, v53, s31 bitop3:0x7e
    v_bitop3_b32 v150, v54, v55, s31 bitop3:0x7e
    v_or3_b32 v12, v149, v150, v149
    v_cmp_ne_u32_sdwa vcc, v12, v148 src0_sel:BYTE_0 src1_sel:DWORD
    s_cbranch_vccz ok_49
    s_mov_b64 exec, vcc
    s_sleep 2
    global_load_dwordx4 v[52:55], v11, s[28:29] sc1
    s_sub_u32 s37, s37, 1
    s_cbranch_scc0 chk_48
    s_branch L_exit
ok_49:
    s_mov_b64 exec, -1
    s_cmp_eq_u32 s32, 7
    s_cbranch_scc1 L_fsum
    global_load_dword v60, v121, s[28:29] sc1
    s_sleep 16
L_fpoll:
    global_load_dwordx4 v[52:55], v118, s[28:29] sc1
    s_waitcnt vmcnt(0)
    v_xor_b32 v12, s8, v52
    v_bitop3_b32 v12, v12, v53, s9 bitop3:0xf6
    v_bitop3_b32 v12, v12, v54, s10 bitop3:0xf6
    v_bitop3_b32 v12, v12, v55, s11 bitop3:0xf6
    v_lshlrev_b32 v56, 16, v52
    v_and_b32 v12, 0x00010001, v12
    v_and_b32 v57, 0xffff0000, v52
    v_cmp_ne_u32 vcc, 0, v12
    s_cbranch_vccz L_fok
    s_sub_u32 s37, s37, 1
    s_cbranch_scc0 L_fpoll
    s_branch L_exit
L_fok:
    v_lshlrev_b32 v58, 16, v53
    v_and_b32 v59, 0xffff0000, v53
    v_lshlrev_b32 v64, 16, v54
    v_and_b32 v65, 0xffff0000, v54
    v_lshlrev_b32 v66, 16, v55
    v_and_b32 v67, 0xffff0000, v55
    v_permlane32_swap_b32 v56, v57
    v_permlane32_swap_b32 v58, v59
    v_permlane32_swap_b32 v64, v65
    v_permlane32_swap_b32 v66, v67
    v_add_f32 v56, v56, v57
    v_add_f32 v58, v58, v59
    v_add_f32 v64, v64, v65
    v_add_f32 v66, v66, v67
    v_permlane16_swap_b32 v56, v58
    s_nop 0
    v_permlane16_swap_b32 v64, v66
    v_add_f32 v57, v56, v58
    v_add_f32 v64, v64, v66
    s_nop 0
    v_add_f32_dpp v56, v57, v57 row_ror:8 row_mask:0xf bank_mask:0x3
    s_nop 1
    v_add_f32_dpp v56, v64, v64 row_ror:8 row_mask:0xf bank_mask:0xc
    s_nop 1
    v_add_f32_dpp v56, v56, v56 row_shr:4 row_mask:0xf bank_mask:0xa
L_fsum:
    s_mov_b32 exec_lo, 0xf0f0f0f0
    s_mov_b32 exec_hi, 0xf0f0f0f0
    ds_write_b32 v119, v56
    s_mov_b64 exec, -1
    s_cmp_lg_u32 s32, 0
    s_cbranch_scc0 L_fin0
    s_waitcnt lgkmcnt(0)
    s_barrier
    s_branch L_exit
L_fin0:
L_hchk:
    v_xor_b32 v12, s31, v60
    v_and_b32 v12, 0xff, v12
    v_cmp_ne_u32 vcc, 0, v12
    s_cbranch_vccnz L_hget
    v_and_b32 v60, 0xffff0000, v60
    v_add_f32 v60, v60, v10
    s_waitcnt lgkmcnt(0)
    s_barrier
    ds_read_b128 v[52:55], v120
    ds_read_b128 v[56:59], v120 offset:512
    s_mov_b32 exec_hi, 0
    s_waitcnt lgkmcnt(1)
    v_add_f32 v52, v52, v53
    v_add_f32 v54, v54, v55
    v_add_f32 v60, v60, v52
    s_waitcnt lgkmcnt(0)
    v_add_f32 v56, v56, v57
    v_add_f32 v58, v58, v59
    v_add_f32 v60, v60, v54
    v_add_f32 v56, v56, v58
    v_add_f32 v52, v60, v56
    v_cvt_pk_bf16_f32 v52, v52, v52
    global_store_short v122, v52, s[24:25]
    s_or_b32 s46, s33, s54
    s_cbranch_scc1 L_exit
    v_mov_b32 v11, 0
    v_mov_b32 v12, s30
    s_mov_b64 exec, 1
    global_store_dword v11, v12, s[28:29]
    s_branch L_exit
L_notop:
    s_barrier
    s_cmp_ge_u32 s32, 4
    s_cbranch_scc1 L_ffn
    s_lshl_b32 s46, s33, 16
    s_lshl_b32 s51, s39, 12
    s_add_u32 s46, s46, s51
    s_lshl_b32 s51, s32, 10
    s_add_u32 s46, s46, s51
    s_add_u32 s46, s46, 1048576
    v_lshlrev_b32 v11, 4, v0
    v_add_u32 v11, s46, v11
    global_load_dwordx4 v[60:63], v11, s[28:29] sc1
    s_branch L_exit
L_ffn:
    s_cmp_ge_u32 s54, s60
    s_cbranch_scc1 L_exit
    s_lshl_b32 s46, s39, 5
    v_add_u32 v9, s46, v9
    s_lshl_b32 s46, s39, 14
    s_add_u32 s62, s62, s46
    s_lshl_b32 s46, s39, 7
    v_add_u32 v129, s46, v129
    v_add_u32 v130, s46, v130
    s_mov_b32 m0, s6
    s_add_u32 s6, s6, 1024
    buffer_load_dwordx4 v124, s[40:43], s61 offen nt lds
    s_add_u32 s61, s61, 114688
    s_mov_b32 m0, s6
    s_add_u32 s6, s6, 1024
    buffer_load_dwordx4 v124, s[40:43], s61 offen nt lds
    s_add_u32 s61, s61, 114688
    s_mov_b32 m0, s6
    s_add_u32 s6, s6, 1024
    buffer_load_dwordx4 v124, s[40:43], s61 offen nt lds
    s_add_u32 s61, s61, 114688
    s_mov_b32 m0, s6
    s_add_u32 s6, s6, 1024
    buffer_load_dwordx4 v124, s[40:43], s61 offen nt lds
    s_add_u32 s61, s61, 114688
    v_xor_b32 v17, 0x80, v125
    s_add_u32 m0, s63, 4096
    s_nop 0
    buffer_load_dwordx4 v125, s[56:59], s62 offen nt lds
    s_add_u32 s62, s62, 4096
    s_add_u32 m0, s63, 5120
    s_nop 0
    buffer_load_dwordx4 v17, s[56:59], s62 offen nt lds
    s_add_u32 s62, s62, 4096
    s_add_u32 m0, s63, 6144
    s_nop 0
    buffer_load_dwordx4 v125, s[56:59], s62 offen nt lds
    s_add_u32 s62, s62, 4096
    s_add_u32 m0, s63, 7168
    s_nop 0
    buffer_load_dwordx4 v17, s[56:59], s62 offen nt lds
    s_add_u32 s62, s62, 4096
    global_load_dword v9, v9, s[18:19]
    s_mov_b32 s50, 0x07060302
    s_mov_b32 s7, 0xfffefffe
    s_mov_b32 s48, 0x3b000000
    s_mov_b32 s49, 0x3b000000
    s_mov_b32 s52, 0xbdd2d3e8
    s_mov_b32 s53, 0xbdd2d3e8
    v_mov_b32 v106, 0xc0135761
    v_mov_b32 v107, 0xc0135761
    s_lshl_b32 s46, s33, 8
    s_lshl_b32 s51, s39, 4
    s_add_u32 s46, s46, s51
    s_add_u32 s46, s46, 4096
    v_mov_b32 v16, s46
    v_mov_b32 v76, v3
    v_mov_b32 v77, v3
    v_mov_b32 v78, v3
    v_mov_b32 v79, v3
    s_waitcnt vmcnt(0)
    v_lshlrev_b32 v104, 16, v9
    v_and_b32 v105, 0xffff0000, v9
    global_load_dwordx4 v[52:55], v128, s[28:29] sc1
    global_load_dwordx4 v[56:59], v128, s[28:29] offset:1024 sc1
    global_load_dwordx4 v[60:63], v128, s[28:29] offset:2048 sc1
    global_load_dwordx4 v[64:67], v128, s[28:29] offset:3072 sc1
    ds_read_b64_tr_b16 v[20:21], v126 offset:0
    ds_read_b64_tr_b16 v[22:23], v126 offset:1024
    ds_read_b64_tr_b16 v[24:25], v126 offset:512
    ds_read_b64_tr_b16 v[26:27], v126 offset:1536
    ds_read_b64_tr_b16 v[28:29], v126 offset:2048
    ds_read_b64_tr_b16 v[30:31], v126 offset:3072
    ds_read_b64_tr_b16 v[32:33], v126 offset:2560
    ds_read_b64_tr_b16 v[34:35], v126 offset:3584
    v_xor_b32 v15, 0, v127
    ds_read_b64_tr_b16 v[36:37], v15 offset:4096
    v_xor_b32 v15, 32, v127
    ds_read_b64_tr_b16 v[38:39], v15 offset:4096
    v_xor_b32 v15, 64, v127
    ds_read_b64_tr_b16 v[40:41], v15 offset:4096
    v_xor_b32 v15, 96, v127
    ds_read_b64_tr_b16 v[42:43], v15 offset:4096
    v_xor_b32 v15, 128, v127
    ds_read_b64_tr_b16 v[44:45], v15 offset:4096
    v_xor_b32 v15, 160, v127
    ds_read_b64_tr_b16 v[46:47], v15 offset:4096
    v_xor_b32 v15, 192, v127
    ds_read_b64_tr_b16 v[48:49], v15 offset:4096
    v_xor_b32 v15, 224, v127
    ds_read_b64_tr_b16 v[50:51], v15 offset:4096
    s_waitcnt lgkmcnt(0)
    v_mfma_f32_16x16x32_bf16 v[84:87], v[20:23], v[140:143], 0
    v_mfma_f32_16x16x32_bf16 v[84:87], v[24:27], v[140:143], v[84:87]
    v_mfma_f32_16x16x32_bf16 v[84:87], v[28:31], v[140:143], v[84:87]
    v_mfma_f32_16x16x32_bf16 v[84:87], v[32:35], v[140:143], v[84:87]
    s_nop 7
    v_mov_b32_dpp v84, v86 quad_perm:[0,1,2,3] row_mask:0xf bank_mask:0xc
    v_mov_b32_dpp v85, v87 quad_perm:[0,1,2,3] row_mask:0xf bank_mask:0xc
    ds_write_b64 v133, v[84:85] offset:2048
    s_waitcnt lgkmcnt(0)
    s_barrier
    ds_read_b128 v[84:87], v134 offset:2048
    ds_read_b128 v[88:91], v134 offset:3072
    s_waitcnt lgkmcnt(0)
    v_add_f32 v84, v84, v86
    v_add_f32 v85, v85, v87
    v_add_f32 v88, v88, v90
    v_add_f32 v89, v89, v91
    v_add_f32 v102, v84, v88
    v_add_f32 v103, v85, v89
chk_50:
    s_waitcnt vmcnt(3)
    v_bitop3_b32 v149, v52, v53, s31 bitop3:0x7e
    v_bitop3_b32 v150, v54, v55, s31 bitop3:0x7e
    v_or3_b32 v15, v149, v150, v149
    s_waitcnt vmcnt(2)
    v_bitop3_b32 v149, v56, v57, s31 bitop3:0x7e
    v_bitop3_b32 v150, v58, v59, s31 bitop3:0x7e
    v_or3_b32 v15, v149, v150, v15
    s_waitcnt vmcnt(1)
    v_bitop3_b32 v149, v60, v61, s31 bitop3:0x7e
    v_bitop3_b32 v150, v62, v63, s31 bitop3:0x7e
    v_or3_b32 v15, v149, v150, v15
    s_waitcnt vmcnt(0)
    v_bitop3_b32 v149, v64, v65, s31 bitop3:0x7e
    v_bitop3_b32 v150, v66, v67, s31 bitop3:0x7e
    v_or3_b32 v15, v149, v150, v15
    v_cmp_ne_u32_sdwa vcc, v15, v148 src0_sel:BYTE_0 src1_sel:DWORD
    s_cbranch_vccz ok_51
    s_mov_b64 exec, vcc
    global_load_dwordx4 v[52:55], v128, s[28:29] sc1
    global_load_dwordx4 v[56:59], v128, s[28:29] offset:1024 sc1
    global_load_dwordx4 v[60:63], v128, s[28:29] offset:2048 sc1
    global_load_dwordx4 v[64:67], v128, s[28:29] offset:3072 sc1
    s_sub_u32 s37, s37, 1
    s_cbranch_scc0 chk_50
    s_branch L_exit
ok_51:
    s_mov_b64 exec, -1
    v_perm_b32 v68, v53, v52, s50
    v_perm_b32 v69, v55, v54, s50
    v_perm_b32 v70, v57, v56, s50
    v_perm_b32 v71, v59, v58, s50
    s_nop 1
    v_mfma_f32_16x16x32_bf16 v[88:91], v[24:27], v[68:71], 0
    v_mfma_f32_16x16x32_bf16 v[84:87], v[20:23], v[68:71], 0
    v_perm_b32 v72, v61, v60, s50
    v_perm_b32 v73, v63, v62, s50
    v_perm_b32 v74, v65, v64, s50
    v_perm_b32 v75, v67, v66, s50
    s_nop 1
    v_mfma_f32_16x16x32_bf16 v[88:91], v[32:35], v[72:75], v[88:91]
    v_mfma_f32_16x16x32_bf16 v[84:87], v[28:31], v[72:75], v[84:87]
    v_dot2_f32_bf16 v92, v68, v140, 0
    v_dot2_f32_bf16 v93, v68, v68, 0
    v_dot2_f32_bf16 v92, v69, v140, v92
    v_dot2_f32_bf16 v93, v69, v69, v93
    v_dot2_f32_bf16 v92, v70, v140, v92
    v_dot2_f32_bf16 v93, v70, v70, v93
    v_dot2_f32_bf16 v92, v71, v140, v92
    v_dot2_f32_bf16 v93, v71, v71, v93
    v_dot2_f32_bf16 v92, v72, v140, v92
    v_dot2_f32_bf16 v93, v72, v72, v93
    v_dot2_f32_bf16 v92, v73, v140, v92
    v_dot2_f32_bf16 v93, v73, v73, v93
    v_dot2_f32_bf16 v92, v74, v140, v92
    v_dot2_f32_bf16 v93, v74, v74, v93
    v_dot2_f32_bf16 v92, v75, v140, v92
    v_dot2_f32_bf16 v93, v75, v75, v93
    v_add_f32_dpp v96, v88, v84 row_ror:8 row_mask:0xf bank_mask:0x3
    v_add_f32_dpp v97, v89, v85 row_ror:8 row_mask:0xf bank_mask:0x3
    s_nop 0
    v_add_f32_dpp v96, v86, v90 row_ror:8 row_mask:0xf bank_mask:0xc
    v_add_f32_dpp v97, v87, v91 row_ror:8 row_mask:0xf bank_mask:0xc
    v_permlane32_swap_b32 v92, v93
    ds_write_b64 v133, v[96:97]
    v_add_f32 v92, v92, v93
    v_mov_b32 v93, v92
    s_nop 1
    v_permlane16_swap_b32 v92, v93
    v_add_f32 v92, v92, v93
    s_nop 1
    v_add_f32_dpp v92, v92, v92 row_ror:8 row_mask:0xf bank_mask:0xf
    ds_write_b32 v135, v92
    s_waitcnt lgkmcnt(0)
    s_barrier
    ds_read_b128 v[52:55], v136
    ds_read_b128 v[56:59], v136 offset:16
    ds_read_b128 v[60:63], v134
    ds_read_b128 v[64:67], v134 offset:1024
    s_cmp_lg_u32 s32, 4
    s_cbranch_scc1 L_nofl
    s_mov_b64 exec, 1
    s_cmp_lg_u32 s38, 1
    s_cbranch_scc1 slow_52
    global_store_dwordx4 v16, v[76:79], s[28:29]
back_53:
    s_mov_b64 exec, -1
L_nofl:
    s_waitcnt lgkmcnt(2)
    v_pk_add_f32 v[52:53], v[52:53], v[54:55]
    v_pk_add_f32 v[56:57], v[56:57], v[58:59]
    v_pk_add_f32 v[52:53], v[52:53], v[56:57]
    v_pk_mul_f32 v[52:53], v[52:53], s[48:49]
    v_fma_f32 v53, -v52, v52, v53
    v_add_f32 v53, 0x3727c5ac, v53
    v_rsq_f32 v53, v53
    s_waitcnt lgkmcnt(0)
    v_pk_add_f32 v[60:61], v[60:61], v[62:63]
    v_pk_add_f32 v[64:65], v[64:65], v[66:67]
    v_pk_add_f32 v[56:57], v[60:61], v[64:65]
    v_pk_fma_f32 v[56:57], v[102:103], v[52:53], v[56:57] op_sel:[0,0,0] op_sel_hi:[1,0,1] neg_lo:[1,0,0] neg_hi:[1,0,0]
    v_pk_fma_f32 v[56:57], v[56:57], v[52:53], v[104:105] op_sel:[0,1,0] op_sel_hi:[1,1,1]
    v_pk_mul_f32 v[58:59], v[56:57], v[56:57]
    v_pk_fma_f32 v[58:59], v[58:59], s[52:53], v[106:107]
    v_pk_mul_f32 v[58:59], v[58:59], v[56:57]
    v_exp_f32 v58, v58
    v_exp_f32 v59, v59
    s_nop 0
    v_pk_add_f32 v[58:59], v[58:59], 1.0 op_sel_hi:[1,0]
    v_rcp_f32 v58, v58
    v_rcp_f32 v59, v59
    s_nop 0
    v_pk_mul_f32 v[56:57], v[56:57], v[58:59]
    v_cvt_pk_bf16_f32 v56, v56, v57
    s_nop 1
    v_mov_b32_dpp v144, v56 quad_perm:[0,1,2,3] row_mask:0xf bank_mask:0x3
    v_mov_b32_dpp v145, v56 row_ror:8 row_mask:0xf bank_mask:0x3
    v_mov_b32_dpp v146, v56 row_ror:8 row_mask:0xf bank_mask:0xc
    v_mov_b32_dpp v147, v56 quad_perm:[0,1,2,3] row_mask:0xf bank_mask:0xc
    s_nop 1
    v_mfma_f32_16x16x32_bf16 v[80:83], v[36:39], v[144:147], 0
    v_mfma_f32_16x16x32_bf16 v[84:87], v[40:43], v[144:147], 0
    v_mfma_f32_16x16x32_bf16 v[88:91], v[44:47], v[144:147], 0
    v_mfma_f32_16x16x32_bf16 v[92:95], v[48:51], v[144:147], 0
    s_nop 4
    v_cvt_pk_bf16_f32 v80, v80, v81
    v_cvt_pk_bf16_f32 v81, v82, v83
    v_and_or_b32 v80, v80, s7, v131
    v_and_or_b32 v81, v81, s7, v132
    ds_write_b64 v117, v[80:81] offset:0
    v_cvt_pk_bf16_f32 v84, v84, v85
    v_cvt_pk_bf16_f32 v85, v86, v87
    v_and_or_b32 v84, v84, s7, v131
    v_and_or_b32 v85, v85, s7, v132
    ds_write_b64 v117, v[84:85] offset:64
    ds_read_b128 v[52:55], v137 offset:0
    v_cvt_pk_bf16_f32 v88, v88, v89
    v_cvt_pk_bf16_f32 v89, v90, v91
    v_and_or_b32 v88, v88, s7, v131
    v_and_or_b32 v89, v89, s7, v132
    ds_write_b64 v117, v[88:89] offset:128
    v_cvt_pk_bf16_f32 v92, v92, v93
    v_cvt_pk_bf16_f32 v93, v94, v95
    v_and_or_b32 v92, v92, s7, v131
    v_and_or_b32 v93, v93, s7, v132
    ds_write_b64 v117, v[92:93] offset:192
    ds_read_b128 v[56:59], v137 offset:128
    s_waitcnt lgkmcnt(3)
    global_store_dwordx4 v129, v[52:55], s[28:29] sc1
    s_waitcnt lgkmcnt(0)
    global_store_dwordx4 v130, v[56:59], s[28:29] sc1
L_exit:
L_end:
    s_endpgm
slow_32:
    global_store_dwordx4 v123, v[88:91], s[28:29] sc1
    s_branch back_33
slow_38:
    global_store_dword v108, v88, s[28:29] sc1
    s_branch back_39
slow_46:
    global_store_dword v116, v52, s[28:29] sc1
    s_branch back_47
L_hget:
    global_load_dword v60, v121, s[28:29] sc1
    s_waitcnt vmcnt(0)
    s_sub_u32 s37, s37, 1
    s_cbranch_scc0 L_hchk
    s_branch L_exit
slow_52:
    global_store_dwordx4 v16, v[76:79], s[28:29] sc1
    s_branch back_53
.section .rodata,"a"
.p2align 6
.amdhsa_kernel sequential_preLN__sliding_block_cached__dense_activation_gelu__decode_kernel
  .amdhsa_next_free_vgpr 152
  .amdhsa_next_free_sgpr 100
  .amdhsa_accum_offset 152
  .amdhsa_group_segment_fixed_size 0
  .amdhsa_kernarg_size 104
  .amdhsa_user_sgpr_count 2
  .amdhsa_user_sgpr_kernarg_segment_ptr 1
  .amdhsa_system_sgpr_workgroup_id_x 1
.end_amdhsa_kernel
```
